```python
import torch

def _softmax(x, axis=-1):
    return torch.softmax(x, dim=axis)
def _gelu(x):
    return torch.nn.functional.gelu(x, approximate="tanh")
def _silu(x):
    return torch.nn.functional.silu(x)
def _sigmoid(x):
    return torch.sigmoid(x)
def _layernorm(x, axis=-1, eps=1e-5):
    m = x.mean(dim=axis, keepdim=True)
    v = x.var(dim=axis, keepdim=True, unbiased=False)
    return (x - m) / torch.sqrt(v + eps)
def _scatter_add(tgt, idx, src, axis=0):
    return tgt.clone().index_add_(axis, idx, src)
def _segment_sum(src, seg, n):
    out = torch.zeros((n,) + src.shape[1:], dtype=src.dtype)
    return out.index_add_(0, seg, src)
def _pad(x, pw):
    flat = tuple(v for pair in reversed(pw) for v in pair)
    return torch.nn.functional.pad(x, flat)

kernel_name = 'concat_heads__gqa_block_cached__sliding_block_cached__decode'

def setup_inputs():

    _w = (lambda a: (lambda t: t.to(torch.bfloat16) if t.is_floating_point() else t)(torch.as_tensor(a)))
    def _A_setup():
        B, Sq, D = 1, 1, 640
        Hq, Hkv, Sk, Dh = 32, 32, 4096, 128
        assert Hq % Hkv == 0, (Hq, Hkv)
        return {
            "x": _w((lambda *s: torch.randn(*s, dtype=torch.bfloat16) * 3.2)(B, Sq, D)),
            "k_cache": _w((lambda *s: torch.randn(*s, dtype=torch.bfloat16) * 6.4)(B, Hkv, Sk, Dh)),
            "v_cache": _w((lambda *s: torch.randn(*s, dtype=torch.bfloat16) * 0.1)(B, Hkv, Sk, Dh)),
            "wq": _w((lambda *s: torch.randn(*s, dtype=torch.bfloat16) * 6.4)(D, Hq * Dh) * (D ** -0.5)),
            "wo": _w((lambda *s: torch.randn(*s, dtype=torch.bfloat16) * 0.1)(Hq * Dh, D) * ((Hq * Dh) ** -0.5)),
        }
    _A_in = _A_setup()

    def _B_setup():
        B, Sq, D = 1, 1, 640
        Hq, Hkv, Sk, Dh = 32, 32, 4096, 128
        assert Hq % Hkv == 0, (Hq, Hkv)
        return {
            "x": _w((lambda *s: torch.randn(*s, dtype=torch.bfloat16) * 1.6)(B, Sq, D)),
            "k_cache": _w((lambda *s: torch.randn(*s, dtype=torch.bfloat16) * 3.2)(B, Hkv, Sk, Dh)),
            "v_cache": _w((lambda *s: torch.randn(*s, dtype=torch.bfloat16) * 0.1)(B, Hkv, Sk, Dh)),
            "wq": _w((lambda *s: torch.randn(*s, dtype=torch.bfloat16) * 3.2)(D, Hq * Dh) * (D ** -0.5)),
            "wo": _w((lambda *s: torch.randn(*s, dtype=torch.bfloat16) * 0.1)(Hq * Dh, D) * ((Hq * Dh) ** -0.5)),
        }
    _B_in = _B_setup()

    return {
        "A_x": _A_in["x"],
        "A_k_cache": _A_in["k_cache"],
        "A_v_cache": _A_in["v_cache"],
        "A_wq": _A_in["wq"],
        "A_wo": _A_in["wo"],
        "B_x": _B_in["x"],
        "B_k_cache": _B_in["k_cache"],
        "B_v_cache": _B_in["v_cache"],
        "B_wq": _B_in["wq"],
        "B_wo": _B_in["wo"],
    }

def reference(A_x, A_k_cache, A_v_cache, A_wq, A_wo, B_x, B_k_cache, B_v_cache, B_wq, B_wo):
    def _A_ref(x, k_cache, v_cache, wq, wo):
        B, Sq, D = x.shape
        Hq, Dh = 32, 128
        Hkv = k_cache.shape[1]
        rep = Hq // Hkv
        q = (lambda x, *d: x.permute(*d))((x @ wq).reshape(B, Sq, Hq, Dh), 0, 2, 1, 3)
        k = (lambda x, n, axis: torch.repeat_interleave(x, n, dim=axis))(k_cache, rep, axis=1)
        v = (lambda x, n, axis: torch.repeat_interleave(x, n, dim=axis))(v_cache, rep, axis=1)
        scores = torch.einsum("bhqd,bhkd->bhqk", q, k) * (Dh ** -0.5)
        p = _softmax(scores, axis=-1)
        o = torch.einsum("bhqk,bhkd->bhqd", p, v)
        return (lambda x, *d: x.permute(*d))(o, 0, 2, 1, 3).reshape(B, Sq, Hq * Dh) @ wo

    def _B_ref(x, k_cache, v_cache, wq, wo):
        B, Sq, D = x.shape
        Hq, Dh = 32, 128
        Hkv, Sk = k_cache.shape[1], k_cache.shape[2]
        W = min(4096, max(256, Sk // 4))
        rep = Hq // Hkv
        q = (lambda x, *d: x.permute(*d))((x @ wq).reshape(B, Sq, Hq, Dh), 0, 2, 1, 3)
        k = (lambda x, n, axis: torch.repeat_interleave(x, n, dim=axis))(k_cache[:, :, Sk - W:, :], rep, axis=1)
        v = (lambda x, n, axis: torch.repeat_interleave(x, n, dim=axis))(v_cache[:, :, Sk - W:, :], rep, axis=1)
        scores = torch.einsum("bhqd,bhkd->bhqk", q, k) * (Dh ** -0.5)
        p = _softmax(scores, axis=-1)
        o = torch.einsum("bhqk,bhkd->bhqd", p, v)
        return (lambda x, *d: x.permute(*d))(o, 0, 2, 1, 3).reshape(B, Sq, Hq * Dh) @ wo

    a = _A_ref(A_x, A_k_cache, A_v_cache, A_wq, A_wo)
    b = _B_ref(B_x, B_k_cache, B_v_cache, B_wq, B_wo)
    return torch.concatenate([a, b], axis=-1)
```

```asm
; @launch grid=(256,1,1) block=(512,1,1) lds=16384
.amdgcn_target "amdgcn-amd-amdhsa--gfx950"
.text
.globl concat_heads__gqa_block_cached__sliding_block_cached__decode_kernel
.p2align 8
.type concat_heads__gqa_block_cached__sliding_block_cached__decode_kernel,@function
concat_heads__gqa_block_cached__sliding_block_cached__decode_kernel:
    s_cmp_ge_u32 s2, 256
    s_cbranch_scc1 L_end
    s_load_dwordx16 s[16:31], s[0:1], 0
    s_load_dwordx4 s[32:35], s[0:1], 64
    s_load_dwordx4 s[36:39], s[0:1], 80
    s_load_dwordx2 s[40:41], s[0:1], 96
    v_lshrrev_b32 v9, 6, v0
    v_and_b32 v0, 63, v0
    v_readfirstlane_b32 s3, v9
    s_and_b32 s4, s2, 7
    s_lshr_b32 s5, s2, 3
    s_and_b32 s6, s5, 24
    s_add_u32 s4, s4, s6
    s_and_b32 s5, s5, 7
    v_lshrrev_b32 v10, 4, v0
    v_and_b32 v11, 15, v0
    v_lshlrev_b32 v12, 4, v11
    v_lshl_add_u32 v3, v10, 13, v12
    v_lshlrev_b32 v13, 3, v11
    v_lshl_add_u32 v13, v10, 1, v13
    v_lshrrev_b32 v14, 2, v11
    v_and_b32 v15, 3, v11
    v_lshlrev_b32 v2, 8, v14
    v_lshl_add_u32 v2, v10, 6, v2
    v_lshl_add_u32 v2, v15, 4, v2
    s_and_b32 s12, s5, 3
    s_lshr_b32 s13, s5, 2
    s_mul_i32 s6, s12, 160
    s_mul_i32 s7, s3, 20
    s_add_u32 s6, s6, s7
    s_lshl_b32 s7, s6, 13
    s_lshl_b32 s8, s4, 8
    s_add_u32 s7, s7, s8
    s_lshl_b32 s8, s6, 1
    s_lshl_b32 s6, s4, 20
    s_lshl_b32 s87, s5, 17
    s_lshl_b32 s9, s3, 12
    s_add_u32 s87, s87, s9
    s_add_u32 s87, s87, s6
    s_lshl_b32 s88, s3, 3
    s_add_u32 s88, s88, s5
    s_lshl_b32 s88, s88, 12
    s_add_u32 s88, s88, s6
    s_add_u32 s88, s88, 786432
    s_mov_b32 s72, 32768
    s_mov_b32 s73, 65536
    s_mov_b32 s74, 98304
    s_mov_b32 s89, 131072
    s_mov_b32 s50, 155904
    s_mov_b32 s51, 0x20000
    s_sub_u32 s46, 1280, s8
    s_mov_b32 s47, 0x20000
    s_mov_b32 s54, 102400
    s_mov_b32 s55, 0x20000
    s_cmp_eq_u32 s13, 1
    s_waitcnt lgkmcnt(0)
    s_cselect_b64 s[16:17], s[26:27], s[16:17]
    s_cselect_b64 s[22:23], s[32:33], s[22:23]
    s_cselect_b64 s[24:25], s[34:35], s[24:25]
    s_add_u32 s44, s16, s8
    s_addc_u32 s45, s17, 0
    s_add_u32 s48, s22, s7
    s_addc_u32 s49, s23, 0
    buffer_load_ushort v228, v13, s[44:47], 0 offen
    buffer_load_dwordx4 v[176:179], v3, s[48:51], 0 offen nt
    buffer_load_dwordx4 v[180:183], v3, s[48:51], s72 offen nt
    buffer_load_dwordx4 v[184:187], v3, s[48:51], s73 offen nt
    buffer_load_dwordx4 v[188:191], v3, s[48:51], s74 offen nt
    buffer_load_dwordx4 v[192:195], v3, s[48:51], s89 offen nt
    s_add_u32 s52, s18, s87
    s_addc_u32 s53, s19, 0
    s_cmp_lg_u32 s3, 0
    s_cbranch_scc1 L_noinit
    v_mov_b32 v232, 0
    v_mov_b32 v233, 0
    v_mov_b32 v234, 0
    v_mov_b32 v235, 0
    v_mul_u32_u24 v9, 288, v0
    v_mov_b32 v14, 0
    s_mov_b64 exec, 0xf
    ds_write_b128 v9, v[232:235] offset:4352
    ds_write_b128 v14, v[232:235] offset:14336
    ds_write_b128 v14, v[232:235] offset:14352
    s_mov_b64 exec, -1
    s_waitcnt lgkmcnt(0)
L_noinit:
    s_barrier
    buffer_load_dwordx4 v[16:19], v2, s[52:55], 0 offen offset:0 nt
    buffer_load_dwordx4 v[20:23], v2, s[52:55], 0 offen offset:1024 nt
    buffer_load_dwordx4 v[24:27], v2, s[52:55], 0 offen offset:2048 nt
    buffer_load_dwordx4 v[28:31], v2, s[52:55], 0 offen offset:3072 nt
    s_load_dword s10, s[40:41], 0
    s_getreg_b32 s86, hwreg(HW_REG_XCC_ID)
    s_and_b32 s6, s2, 7
    s_lshr_b32 s7, s2, 3
    s_lshr_b32 s93, s6, 1
    s_mul_i32 s93, s93, 20
    s_add_u32 s93, s93, s7
    s_cmp_lt_u32 s7, 20
    s_cselect_b32 s92, 1, 0
    s_bitcmp1_b32 s2, 0
    s_cselect_b32 s92, 0, s92
    s_cmp_eq_u32 s3, 7
    s_cselect_b32 s90, 4, s3
    s_cselect_b32 s91, 1, 0
    s_cmp_lt_u32 s3, 4
    s_cselect_b32 s91, 1, s91
    s_add_u32 s56, s20, s87
    s_addc_u32 s57, s21, 0
    s_mov_b32 s58, 102400
    s_mov_b32 s59, 0x20000
    s_add_u32 s60, s28, s88
    s_addc_u32 s61, s29, 0
    s_mov_b32 s62, 4096
    s_mov_b32 s63, 0x20000
    s_add_u32 s64, s30, s88
    s_addc_u32 s65, s31, 0
    s_mov_b32 s66, 4096
    s_mov_b32 s67, 0x20000
    v_lshlrev_b32 v1, 4, v0
    v_mul_u32_u24 v4, 1280, v10
    v_add_u32 v4, v4, v12
    v_lshlrev_b32 v12, 6, v10
    v_lshl_add_u32 v12, v15, 4, v12
    v_mov_b32 v13, 256
    s_mov_b32 s76, 0x000f000f
    s_mov_b32 s77, 0x000f000f
    s_mov_b32 s78, 0x00f000f0
    s_mov_b32 s79, 0x00f000f0
    s_mov_b32 s80, 0x0f000f00
    s_mov_b32 s81, 0x0f000f00
    s_mov_b32 s82, 0xf000f000
    s_mov_b32 s83, 0xf000f000
    v_cndmask_b32_e64 v251, v13, v12, s[76:77]
    v_cndmask_b32_e64 v252, v13, v12, s[78:79]
    v_cndmask_b32_e64 v253, v13, v12, s[80:81]
    v_cndmask_b32_e64 v254, v13, v12, s[82:83]
    v_and_b32 v14, 1, v0
    v_lshlrev_b32 v14, 4, v14
    v_mov_b32 v15, 0xffff
    v_lshlrev_b32 v14, v14, v15
    s_mov_b32 s76, 0x03030303
    s_mov_b32 s77, 0x03030303
    s_mov_b32 s78, 0x0c0c0c0c
    s_mov_b32 s79, 0x0c0c0c0c
    s_mov_b32 s80, 0x30303030
    s_mov_b32 s81, 0x30303030
    s_mov_b32 s82, 0xc0c0c0c0
    s_mov_b32 s83, 0xc0c0c0c0
    v_cndmask_b32_e64 v5, 0, v14, s[76:77]
    v_cndmask_b32_e64 v6, 0, v14, s[78:79]
    v_cndmask_b32_e64 v7, 0, v14, s[80:81]
    v_cndmask_b32_e64 v8, 0, v14, s[82:83]
    s_waitcnt vmcnt(9)
    v_lshl_or_b32 v228, v228, 16, v228
    s_nop 1
    v_and_b32_dpp v208, v228, v5 row_newbcast:0 row_mask:0xf bank_mask:0xf
    v_and_b32_dpp v209, v228, v6 row_newbcast:0 row_mask:0xf bank_mask:0xf
    v_and_b32_dpp v210, v228, v7 row_newbcast:0 row_mask:0xf bank_mask:0xf
    v_and_b32_dpp v211, v228, v8 row_newbcast:0 row_mask:0xf bank_mask:0xf
    v_and_b32_dpp v212, v228, v5 row_newbcast:1 row_mask:0xf bank_mask:0xf
    v_and_b32_dpp v213, v228, v6 row_newbcast:1 row_mask:0xf bank_mask:0xf
    v_and_b32_dpp v214, v228, v7 row_newbcast:1 row_mask:0xf bank_mask:0xf
    v_and_b32_dpp v215, v228, v8 row_newbcast:1 row_mask:0xf bank_mask:0xf
    s_waitcnt vmcnt(8)
    v_mfma_f32_16x16x32_bf16 v[216:219], v[208:211], v[176:179], 0
    v_and_b32_dpp v208, v228, v5 row_newbcast:2 row_mask:0xf bank_mask:0xf
    v_and_b32_dpp v209, v228, v6 row_newbcast:2 row_mask:0xf bank_mask:0xf
    v_and_b32_dpp v210, v228, v7 row_newbcast:2 row_mask:0xf bank_mask:0xf
    v_and_b32_dpp v211, v228, v8 row_newbcast:2 row_mask:0xf bank_mask:0xf
    s_waitcnt vmcnt(7)
    v_mfma_f32_16x16x32_bf16 v[216:219], v[212:215], v[180:183], v[216:219]
    v_and_b32_dpp v212, v228, v5 row_newbcast:3 row_mask:0xf bank_mask:0xf
    v_and_b32_dpp v213, v228, v6 row_newbcast:3 row_mask:0xf bank_mask:0xf
    v_and_b32_dpp v214, v228, v7 row_newbcast:3 row_mask:0xf bank_mask:0xf
    v_and_b32_dpp v215, v228, v8 row_newbcast:3 row_mask:0xf bank_mask:0xf
    s_waitcnt vmcnt(6)
    v_mfma_f32_16x16x32_bf16 v[216:219], v[208:211], v[184:187], v[216:219]
    v_and_b32_dpp v208, v228, v5 row_newbcast:4 row_mask:0xf bank_mask:0xf
    v_and_b32_dpp v209, v228, v6 row_newbcast:4 row_mask:0xf bank_mask:0xf
    v_and_b32_dpp v210, v228, v7 row_newbcast:4 row_mask:0xf bank_mask:0xf
    v_and_b32_dpp v211, v228, v8 row_newbcast:4 row_mask:0xf bank_mask:0xf
    s_waitcnt vmcnt(5)
    v_mfma_f32_16x16x32_bf16 v[216:219], v[212:215], v[188:191], v[216:219]
    s_nop 1
    s_waitcnt vmcnt(4)
    v_mfma_f32_16x16x32_bf16 v[216:219], v[208:211], v[192:195], v[216:219]
    v_lshlrev_b32 v250, 5, v11
    v_lshl_add_u32 v250, v10, 4, v250
    s_lshl_b32 s6, s3, 9
    v_add_u32 v250, s6, v250
    s_mov_b32 s48, s40
    s_mov_b32 s49, s41
    s_mov_b32 s50, 1835008
    s_mov_b32 s51, 0x20000
    v_mov_b32 v14, 0
    v_mov_b32 v15, 1
    s_mov_b32 exec_hi, 0
    s_nop 0
    ds_write_b128 v250, v[216:219] offset:0
    s_mov_b64 exec, 1
    ds_add_u32 v14, v15 offset:14336
    s_mov_b64 exec, -1
    s_waitcnt lgkmcnt(0)
    s_add_u32 s10, s10, 1
    s_cmp_lg_u32 s3, 7
    s_cbranch_scc1 L_bulk
    s_setprio 3
L_cntq:
    ds_read_b32 v15, v14 offset:14336
    s_waitcnt lgkmcnt(0)
    v_cmp_ne_u32 vcc, 8, v15
    s_cbranch_vccz L_cntq_done
    s_sleep 1
    s_branch L_cntq
L_cntq_done:
    v_lshlrev_b32 v12, 3, v0
    ds_read_b64 v[208:209], v12 offset:0
    ds_read_b64 v[210:211], v12 offset:512
    ds_read_b64 v[212:213], v12 offset:1024
    ds_read_b64 v[214:215], v12 offset:1536
    ds_read_b64 v[216:217], v12 offset:2048
    ds_read_b64 v[218:219], v12 offset:2560
    ds_read_b64 v[220:221], v12 offset:3072
    ds_read_b64 v[222:223], v12 offset:3584
    s_waitcnt lgkmcnt(0)
    v_add_f32 v208, v208, v216
    v_add_f32 v209, v209, v217
    v_add_f32 v210, v210, v218
    v_add_f32 v211, v211, v219
    v_add_f32 v212, v212, v220
    v_add_f32 v213, v213, v221
    v_add_f32 v214, v214, v222
    v_add_f32 v215, v215, v223
    v_add_f32 v208, v208, v212
    v_add_f32 v209, v209, v213
    v_add_f32 v210, v210, v214
    v_add_f32 v211, v211, v215
    v_add_f32 v208, v208, v210
    v_add_f32 v209, v209, v211
    v_mov_b32 v232, v208
    v_mov_b32 v233, v209
    v_mov_b32 v234, s86
    v_mov_b32 v235, s10
    s_lshl_b32 s6, s4, 13
    s_add_u32 s6, s6, 4096
    s_lshl_b32 s7, s5, 10
    s_add_u32 s7, s7, s6
    buffer_store_dwordx4 v[232:235], v1, s[48:51], s7 offen
    s_add_u32 s87, s7, 274432
    s_mov_b32 s88, 0
    s_xor_b32 s9, s10, 1
    v_mov_b32 v179, s9
    v_mov_b32 v183, s9
    v_mov_b32 v187, s9
    v_mov_b32 v191, s9
    v_mov_b32 v195, s9
    v_mov_b32 v199, s9
    v_mov_b32 v203, s9
    v_mov_b32 v207, s9
    s_mov_b32 s11, 0
L_poll0:
    s_mov_b32 s9, s6
    s_cmp_lt_u32 s11, 16
    s_cbranch_scc1 L_p0go
    s_cmp_eq_u32 s88, 1
    s_cbranch_scc1 L_p0alt
    buffer_store_dwordx4 v[232:235], v1, s[48:51], s87 offen sc1
    s_mov_b32 s88, 1
L_p0alt:
    s_bitcmp1_b32 s11, 0
    s_cbranch_scc0 L_p0go
    s_add_u32 s9, s9, 274432
L_p0go:
    v_cmp_ne_u32 vcc, s10, v179
    s_mov_b64 exec, vcc
    s_cbranch_execz L_p0skip0
    buffer_load_dwordx4 v[176:179], v1, s[48:51], s9 offen sc1
L_p0skip0:
    s_mov_b64 exec, -1
    s_add_u32 s9, s9, 1024
    v_cmp_ne_u32 vcc, s10, v183
    s_mov_b64 exec, vcc
    s_cbranch_execz L_p0skip1
    buffer_load_dwordx4 v[180:183], v1, s[48:51], s9 offen sc1
L_p0skip1:
    s_mov_b64 exec, -1
    s_add_u32 s9, s9, 1024
    v_cmp_ne_u32 vcc, s10, v187
    s_mov_b64 exec, vcc
    s_cbranch_execz L_p0skip2
    buffer_load_dwordx4 v[184:187], v1, s[48:51], s9 offen sc1
L_p0skip2:
    s_mov_b64 exec, -1
    s_add_u32 s9, s9, 1024
    v_cmp_ne_u32 vcc, s10, v191
    s_mov_b64 exec, vcc
    s_cbranch_execz L_p0skip3
    buffer_load_dwordx4 v[188:191], v1, s[48:51], s9 offen sc1
L_p0skip3:
    s_mov_b64 exec, -1
    s_add_u32 s9, s9, 1024
    v_cmp_ne_u32 vcc, s10, v195
    s_mov_b64 exec, vcc
    s_cbranch_execz L_p0skip4
    buffer_load_dwordx4 v[192:195], v1, s[48:51], s9 offen sc1
L_p0skip4:
    s_mov_b64 exec, -1
    s_add_u32 s9, s9, 1024
    v_cmp_ne_u32 vcc, s10, v199
    s_mov_b64 exec, vcc
    s_cbranch_execz L_p0skip5
    buffer_load_dwordx4 v[196:199], v1, s[48:51], s9 offen sc1
L_p0skip5:
    s_mov_b64 exec, -1
    s_add_u32 s9, s9, 1024
    v_cmp_ne_u32 vcc, s10, v203
    s_mov_b64 exec, vcc
    s_cbranch_execz L_p0skip6
    buffer_load_dwordx4 v[200:203], v1, s[48:51], s9 offen sc1
L_p0skip6:
    s_mov_b64 exec, -1
    s_add_u32 s9, s9, 1024
    v_cmp_ne_u32 vcc, s10, v207
    s_mov_b64 exec, vcc
    s_cbranch_execz L_p0skip7
    buffer_load_dwordx4 v[204:207], v1, s[48:51], s9 offen sc1
L_p0skip7:
    s_mov_b64 exec, -1
    s_waitcnt vmcnt(0)
    v_xor_b32 v15, s10, v179
    v_xor_b32 v13, s10, v183
    v_or_b32 v15, v15, v13
    v_xor_b32 v13, s10, v187
    v_or_b32 v15, v15, v13
    v_xor_b32 v13, s10, v191
    v_or_b32 v15, v15, v13
    v_xor_b32 v13, s10, v195
    v_or_b32 v15, v15, v13
    v_xor_b32 v13, s10, v199
    v_or_b32 v15, v15, v13
    v_xor_b32 v13, s10, v203
    v_or_b32 v15, v15, v13
    v_xor_b32 v13, s10, v207
    v_or_b32 v15, v15, v13
    v_cmp_ne_u32 vcc, 0, v15
    s_cbranch_vccz L_poll0_done
    s_add_u32 s11, s11, 1
    s_cmp_lt_u32 s11, 400000
    s_cbranch_scc1 L_poll0
L_poll0_done:
    v_xor_b32 v15, s86, v178
    v_xor_b32 v13, s86, v182
    v_or_b32 v15, v15, v13
    v_xor_b32 v13, s86, v186
    v_or_b32 v15, v15, v13
    v_xor_b32 v13, s86, v190
    v_or_b32 v15, v15, v13
    v_xor_b32 v13, s86, v194
    v_or_b32 v15, v15, v13
    v_xor_b32 v13, s86, v198
    v_or_b32 v15, v15, v13
    v_xor_b32 v13, s86, v202
    v_or_b32 v15, v15, v13
    v_xor_b32 v13, s86, v206
    v_or_b32 v15, v15, v13
    v_cmp_ne_u32 vcc, 0, v15
    s_cmp_eq_u64 vcc, 0
    s_cselect_b32 s85, 1, 0
    s_or_b32 s9, s85, s88
    s_cmp_eq_u32 s9, 0
    s_cbranch_scc0 L_p0noslow
    buffer_store_dwordx4 v[232:235], v1, s[48:51], s87 offen sc1
L_p0noslow:
    s_mov_b32 s6, 0x3e0293ee
    s_mov_b32 s84, 0x07060302
    v_lshlrev_b32 v12, 2, v0
    v_add_f32 v176, v176, v180
    v_add_f32 v184, v184, v188
    v_add_f32 v177, v177, v181
    v_add_f32 v185, v185, v189
    v_add_f32 v176, v176, v184
    v_add_f32 v177, v177, v185
    v_mul_f32 v176, s6, v176
    v_mul_f32 v177, s6, v177
    v_perm_b32 v180, v177, v176, s84
    v_and_b32 v181, 0xffff0000, v176
    v_and_b32 v182, 0xffff0000, v177
    v_sub_f32 v181, v176, v181
    v_sub_f32 v182, v177, v182
    v_cvt_pk_bf16_f32 v181, v181, v182
    ds_write_b32 v12, v180 offset:4096
    ds_write_b32 v12, v181 offset:4384
    v_add_f32 v192, v192, v196
    v_add_f32 v200, v200, v204
    v_add_f32 v193, v193, v197
    v_add_f32 v201, v201, v205
    v_add_f32 v192, v192, v200
    v_add_f32 v193, v193, v201
    v_mul_f32 v192, s6, v192
    v_mul_f32 v193, s6, v193
    v_perm_b32 v196, v193, v192, s84
    v_and_b32 v197, 0xffff0000, v192
    v_and_b32 v198, 0xffff0000, v193
    v_sub_f32 v197, v192, v197
    v_sub_f32 v198, v193, v198
    v_cvt_pk_bf16_f32 v197, v197, v198
    ds_write_b32 v12, v196 offset:4672
    ds_write_b32 v12, v197 offset:4960
L_abl_flag:
    v_mov_b32 v14, 1
    v_mov_b32 v15, s85
    v_mov_b32 v13, 0
    s_mov_b64 exec, 1
    ds_write_b64 v13, v[14:15] offset:14344
    s_mov_b64 exec, -1
L_bulk:
    s_setprio 0
    s_cmp_eq_u32 s3, 7
    s_cbranch_scc1 L_nothr1
    s_waitcnt vmcnt(2)
L_nothr1:
    s_waitcnt vmcnt(8)
    buffer_load_dwordx4 v[32:35], v2, s[52:55], s72 offen offset:0 nt
    buffer_load_dwordx4 v[36:39], v2, s[52:55], s72 offen offset:1024 nt
    buffer_load_dwordx4 v[40:43], v2, s[52:55], s72 offen offset:2048 nt
    buffer_load_dwordx4 v[44:47], v2, s[52:55], s72 offen offset:3072 nt
    s_cbranch_scc1 L_nothr2
    s_waitcnt vmcnt(2)
L_nothr2:
    s_waitcnt vmcnt(8)
    buffer_load_dwordx4 v[48:51], v2, s[52:55], s73 offen offset:0 nt
    buffer_load_dwordx4 v[52:55], v2, s[52:55], s73 offen offset:1024 nt
    buffer_load_dwordx4 v[56:59], v2, s[52:55], s73 offen offset:2048 nt
    buffer_load_dwordx4 v[60:63], v2, s[52:55], s73 offen offset:3072 nt
    s_cbranch_scc1 L_nothr3
    s_waitcnt vmcnt(2)
L_nothr3:
    s_waitcnt vmcnt(8)
    buffer_load_dwordx4 v[64:67], v2, s[52:55], s74 offen offset:0 nt
    buffer_load_dwordx4 v[68:71], v2, s[52:55], s74 offen offset:1024 nt
    buffer_load_dwordx4 v[72:75], v2, s[52:55], s74 offen offset:2048 nt
    buffer_load_dwordx4 v[76:79], v2, s[52:55], s74 offen offset:3072 nt
    s_cbranch_scc1 L_nothr4
    s_waitcnt vmcnt(2)
L_nothr4:
    s_waitcnt vmcnt(8)
    buffer_load_dwordx4 v[80:83], v2, s[60:63], 0 offen offset:0 nt
    buffer_load_dwordx4 v[84:87], v2, s[60:63], 0 offen offset:1024 nt
    buffer_load_dwordx4 v[88:91], v2, s[60:63], 0 offen offset:2048 nt
    buffer_load_dwordx4 v[92:95], v2, s[60:63], 0 offen offset:3072 nt
L_afterK:
    s_cmp_ge_u32 s3, 4
    s_cbranch_scc0 L_noyp
    s_setprio 1
L_noyp:
    s_waitcnt vmcnt(2)
    buffer_load_dwordx4 v[96:99], v1, s[56:59], 0 offen offset:0 nt
    buffer_load_dwordx4 v[100:103], v1, s[56:59], 0 offen offset:1024 nt
    buffer_load_dwordx4 v[104:107], v1, s[56:59], 0 offen offset:2048 nt
    buffer_load_dwordx4 v[108:111], v1, s[56:59], 0 offen offset:3072 nt
    v_mov_b32 v13, 0
L_flagq:
    ds_read_b64 v[14:15], v13 offset:14344
    s_waitcnt lgkmcnt(0)
    v_cmp_ne_u32 vcc, 1, v14
    s_cbranch_vccz L_flagq_done
    s_sleep 2
    s_branch L_flagq
L_flagq_done:
    v_readfirstlane_b32 s85, v15
    s_lshl_b32 s7, s4, 7
    s_lshl_b32 s8, s12, 5
    s_add_u32 s7, s7, s8
    s_mul_i32 s7, s7, 1280
    s_lshl_b32 s6, s90, 8
    s_add_u32 s6, s6, s7
    s_add_u32 s44, s24, s6
    s_addc_u32 s45, s25, 0
    s_cmp_eq_u32 s91, 1
    s_cselect_b32 s46, 39936, 0
    s_mov_b32 s47, 0x20000
    ds_read_b128 v[176:179], v251 offset:4096
    ds_read_b128 v[180:183], v251 offset:4384
    ds_read_b128 v[184:187], v252 offset:4096
    ds_read_b128 v[188:191], v252 offset:4384
    ds_read_b128 v[192:195], v253 offset:4096
    ds_read_b128 v[196:199], v253 offset:4384
    ds_read_b128 v[200:203], v254 offset:4096
    ds_read_b128 v[204:207], v254 offset:4384
    s_waitcnt vmcnt(8) lgkmcnt(0)
    v_mfma_f32_16x16x32_bf16 v[208:211], v[16:19], v[176:179], 0
    v_mfma_f32_16x16x32_bf16 v[208:211], v[16:19], v[180:183], v[208:211]
    v_mfma_f32_16x16x32_bf16 v[208:211], v[20:23], v[184:187], v[208:211]
    v_mfma_f32_16x16x32_bf16 v[208:211], v[20:23], v[188:191], v[208:211]
    v_mfma_f32_16x16x32_bf16 v[208:211], v[24:27], v[192:195], v[208:211]
    v_mfma_f32_16x16x32_bf16 v[208:211], v[24:27], v[196:199], v[208:211]
    v_mfma_f32_16x16x32_bf16 v[208:211], v[28:31], v[200:203], v[208:211]
    v_mfma_f32_16x16x32_bf16 v[208:211], v[28:31], v[204:207], v[208:211]
    s_waitcnt vmcnt(2)
    buffer_load_dwordx4 v[112:115], v1, s[56:59], s72 offen offset:0 nt
    buffer_load_dwordx4 v[116:119], v1, s[56:59], s72 offen offset:1024 nt
    buffer_load_dwordx4 v[120:123], v1, s[56:59], s72 offen offset:2048 nt
    buffer_load_dwordx4 v[124:127], v1, s[56:59], s72 offen offset:3072 nt
    v_mfma_f32_16x16x32_bf16 v[212:215], v[32:35], v[176:179], 0
    v_mfma_f32_16x16x32_bf16 v[212:215], v[32:35], v[180:183], v[212:215]
    v_mfma_f32_16x16x32_bf16 v[212:215], v[36:39], v[184:187], v[212:215]
    v_mfma_f32_16x16x32_bf16 v[212:215], v[36:39], v[188:191], v[212:215]
    v_mfma_f32_16x16x32_bf16 v[212:215], v[40:43], v[192:195], v[212:215]
    v_mfma_f32_16x16x32_bf16 v[212:215], v[40:43], v[196:199], v[212:215]
    v_mfma_f32_16x16x32_bf16 v[212:215], v[44:47], v[200:203], v[212:215]
    v_mfma_f32_16x16x32_bf16 v[212:215], v[44:47], v[204:207], v[212:215]
    s_waitcnt vmcnt(2)
    buffer_load_dwordx4 v[128:131], v1, s[56:59], s73 offen offset:0 nt
    buffer_load_dwordx4 v[132:135], v1, s[56:59], s73 offen offset:1024 nt
    buffer_load_dwordx4 v[136:139], v1, s[56:59], s73 offen offset:2048 nt
    buffer_load_dwordx4 v[140:143], v1, s[56:59], s73 offen offset:3072 nt
    v_mfma_f32_16x16x32_bf16 v[216:219], v[48:51], v[176:179], 0
    v_mfma_f32_16x16x32_bf16 v[216:219], v[48:51], v[180:183], v[216:219]
    v_mfma_f32_16x16x32_bf16 v[216:219], v[52:55], v[184:187], v[216:219]
    v_mfma_f32_16x16x32_bf16 v[216:219], v[52:55], v[188:191], v[216:219]
    v_mfma_f32_16x16x32_bf16 v[216:219], v[56:59], v[192:195], v[216:219]
    v_mfma_f32_16x16x32_bf16 v[216:219], v[56:59], v[196:199], v[216:219]
    v_mfma_f32_16x16x32_bf16 v[216:219], v[60:63], v[200:203], v[216:219]
    v_mfma_f32_16x16x32_bf16 v[216:219], v[60:63], v[204:207], v[216:219]
    s_waitcnt vmcnt(2)
    buffer_load_dwordx4 v[144:147], v1, s[56:59], s74 offen offset:0 nt
    buffer_load_dwordx4 v[148:151], v1, s[56:59], s74 offen offset:1024 nt
    buffer_load_dwordx4 v[152:155], v1, s[56:59], s74 offen offset:2048 nt
    buffer_load_dwordx4 v[156:159], v1, s[56:59], s74 offen offset:3072 nt
    v_mfma_f32_16x16x32_bf16 v[220:223], v[64:67], v[176:179], 0
    v_mfma_f32_16x16x32_bf16 v[220:223], v[64:67], v[180:183], v[220:223]
    v_mfma_f32_16x16x32_bf16 v[220:223], v[68:71], v[184:187], v[220:223]
    v_mfma_f32_16x16x32_bf16 v[220:223], v[68:71], v[188:191], v[220:223]
    v_mfma_f32_16x16x32_bf16 v[220:223], v[72:75], v[192:195], v[220:223]
    v_mfma_f32_16x16x32_bf16 v[220:223], v[72:75], v[196:199], v[220:223]
    v_mfma_f32_16x16x32_bf16 v[220:223], v[76:79], v[200:203], v[220:223]
    v_mfma_f32_16x16x32_bf16 v[220:223], v[76:79], v[204:207], v[220:223]
    ds_read_b128 v[176:179], v251 offset:4672
    ds_read_b128 v[180:183], v251 offset:4960
    ds_read_b128 v[184:187], v252 offset:4672
    ds_read_b128 v[188:191], v252 offset:4960
    ds_read_b128 v[192:195], v253 offset:4672
    ds_read_b128 v[196:199], v253 offset:4960
    ds_read_b128 v[200:203], v254 offset:4672
    ds_read_b128 v[204:207], v254 offset:4960
    s_waitcnt vmcnt(2)
    buffer_load_dwordx4 v[160:163], v1, s[64:67], 0 offen offset:0 nt
    buffer_load_dwordx4 v[164:167], v1, s[64:67], 0 offen offset:1024 nt
    buffer_load_dwordx4 v[168:171], v1, s[64:67], 0 offen offset:2048 nt
    buffer_load_dwordx4 v[172:175], v1, s[64:67], 0 offen offset:3072 nt
    s_waitcnt vmcnt(16) lgkmcnt(0)
    v_mfma_f32_16x16x32_bf16 v[224:227], v[80:83], v[176:179], 0
    v_mfma_f32_16x16x32_bf16 v[224:227], v[80:83], v[180:183], v[224:227]
    v_mfma_f32_16x16x32_bf16 v[224:227], v[84:87], v[184:187], v[224:227]
    v_mfma_f32_16x16x32_bf16 v[224:227], v[84:87], v[188:191], v[224:227]
    v_mfma_f32_16x16x32_bf16 v[224:227], v[88:91], v[192:195], v[224:227]
    v_mfma_f32_16x16x32_bf16 v[224:227], v[88:91], v[196:199], v[224:227]
    v_mfma_f32_16x16x32_bf16 v[224:227], v[92:95], v[200:203], v[224:227]
    v_mfma_f32_16x16x32_bf16 v[224:227], v[92:95], v[204:207], v[224:227]
    s_mov_b32 s76, 0xaaaaaaaa
    s_mov_b32 s77, 0xaaaaaaaa
    s_mov_b32 s78, 0xcccccccc
    s_mov_b32 s79, 0xcccccccc
    v_cndmask_b32_e64 v228, v208, v209, s[76:77]
    v_cndmask_b32_e64 v233, v210, v211, s[76:77]
    v_cndmask_b32_e64 v229, v212, v213, s[76:77]
    v_cndmask_b32_e64 v234, v214, v215, s[76:77]
    v_cndmask_b32_e64 v230, v216, v217, s[76:77]
    v_cndmask_b32_e64 v235, v218, v219, s[76:77]
    v_cndmask_b32_e64 v231, v220, v221, s[76:77]
    v_cndmask_b32_e64 v236, v222, v223, s[76:77]
    v_cndmask_b32_e64 v232, v224, v225, s[76:77]
    v_cndmask_b32_e64 v237, v226, v227, s[76:77]
    v_cndmask_b32_e64 v238, v228, v233, s[78:79]
    v_cndmask_b32_e64 v239, v229, v234, s[78:79]
    v_cndmask_b32_e64 v240, v230, v235, s[78:79]
    v_cndmask_b32_e64 v241, v231, v236, s[78:79]
    v_cndmask_b32_e64 v242, v232, v237, s[78:79]
    v_add_f32_dpp v238, v238, v238 quad_perm:[1,0,3,2] row_mask:0xf bank_mask:0xf
    v_add_f32_dpp v239, v239, v239 quad_perm:[1,0,3,2] row_mask:0xf bank_mask:0xf
    v_add_f32_dpp v240, v240, v240 quad_perm:[1,0,3,2] row_mask:0xf bank_mask:0xf
    v_add_f32_dpp v241, v241, v241 quad_perm:[1,0,3,2] row_mask:0xf bank_mask:0xf
    v_add_f32_dpp v242, v242, v242 quad_perm:[1,0,3,2] row_mask:0xf bank_mask:0xf
    v_add_f32_dpp v238, v238, v238 quad_perm:[2,3,0,1] row_mask:0xf bank_mask:0xf
    v_add_f32_dpp v239, v239, v239 quad_perm:[2,3,0,1] row_mask:0xf bank_mask:0xf
    v_add_f32_dpp v240, v240, v240 quad_perm:[2,3,0,1] row_mask:0xf bank_mask:0xf
    v_add_f32_dpp v241, v241, v241 quad_perm:[2,3,0,1] row_mask:0xf bank_mask:0xf
    v_add_f32_dpp v242, v242, v242 quad_perm:[2,3,0,1] row_mask:0xf bank_mask:0xf
    v_max3_f32 v248, v238, v239, v240
    v_mov_b32 v249, v242
    v_max_f32 v248, v248, v241
    s_nop 0
    s_nop 0
    v_max_f32_dpp v249, v249, v249 row_ror:4 row_mask:0xf bank_mask:0xf
    v_max_f32_dpp v248, v248, v248 row_ror:4 row_mask:0xf bank_mask:0xf
    s_nop 0
    v_max_f32_dpp v249, v249, v249 row_ror:8 row_mask:0xf bank_mask:0xf
    v_max_f32_dpp v248, v248, v248 row_ror:8 row_mask:0xf bank_mask:0xf
    s_nop 0
    v_max_f32_dpp v249, v249, v249 row_bcast:15 row_mask:0xa bank_mask:0xf
    v_max_f32_dpp v248, v248, v248 row_bcast:15 row_mask:0xa bank_mask:0xf
    s_nop 0
    v_max_f32_dpp v249, v249, v249 row_bcast:31 row_mask:0xc bank_mask:0xf
    v_max_f32_dpp v248, v248, v248 row_bcast:31 row_mask:0xc bank_mask:0xf
    v_readlane_b32 s42, v249, 63
    v_readlane_b32 s14, v248, 63
    s_nop 1
    v_subrev_f32 v238, s14, v238
    v_subrev_f32 v239, s14, v239
    v_subrev_f32 v240, s14, v240
    v_subrev_f32 v241, s14, v241
    v_subrev_f32 v242, s42, v242
    v_exp_f32 v238, v238
    v_exp_f32 v239, v239
    v_exp_f32 v240, v240
    v_exp_f32 v241, v241
    v_exp_f32 v242, v242
    s_nop 0
    v_cvt_pk_bf16_f32 v243, v238, v238
    v_cvt_pk_bf16_f32 v244, v239, v239
    v_cvt_pk_bf16_f32 v245, v240, v240
    v_cvt_pk_bf16_f32 v246, v241, v241
    v_cvt_pk_bf16_f32 v247, v242, v242
    v_and_b32 v238, 0xffff0000, v243
    v_and_b32 v239, 0xffff0000, v244
    v_and_b32 v240, 0xffff0000, v245
    v_and_b32 v241, 0xffff0000, v246
    v_and_b32 v242, 0xffff0000, v247
    v_add_f32 v238, v238, v239
    v_add_f32 v240, v240, v241
    v_add_f32 v238, v238, v240
    s_nop 0
    s_nop 0
    v_add_f32_dpp v242, v242, v242 row_ror:4 row_mask:0xf bank_mask:0xf
    v_add_f32_dpp v238, v238, v238 row_ror:4 row_mask:0xf bank_mask:0xf
    s_nop 0
    v_add_f32_dpp v242, v242, v242 row_ror:8 row_mask:0xf bank_mask:0xf
    v_add_f32_dpp v238, v238, v238 row_ror:8 row_mask:0xf bank_mask:0xf
    s_nop 0
    v_add_f32_dpp v242, v242, v242 row_bcast:15 row_mask:0xa bank_mask:0xf
    v_add_f32_dpp v238, v238, v238 row_bcast:15 row_mask:0xa bank_mask:0xf
    s_nop 0
    v_add_f32_dpp v242, v242, v242 row_bcast:31 row_mask:0xc bank_mask:0xf
    v_add_f32_dpp v238, v238, v238 row_bcast:31 row_mask:0xc bank_mask:0xf
    v_readlane_b32 s43, v242, 63
    v_readlane_b32 s15, v238, 63
    s_nop 1
    s_lshl_b32 s6, s3, 3
    v_mov_b32 v15, s6
    v_mov_b32 v228, s14
    v_mov_b32 v229, s15
    v_mov_b32 v230, s42
    v_mov_b32 v231, s43
    v_mov_b32 v13, 0
    v_mov_b32 v14, 1
    s_mov_b64 exec, 1
    ds_write_b64 v15, v[228:229] offset:5248
    ds_write_b64 v15, v[230:231] offset:5312
    ds_add_u32 v13, v14 offset:14340
    s_mov_b64 exec, -1
    v_and_b32_dpp v176, v243, v5 row_newbcast:0 row_mask:0xf bank_mask:0xf
    v_and_b32_dpp v177, v243, v6 row_newbcast:0 row_mask:0xf bank_mask:0xf
    v_and_b32_dpp v178, v243, v7 row_newbcast:0 row_mask:0xf bank_mask:0xf
    v_and_b32_dpp v179, v243, v8 row_newbcast:0 row_mask:0xf bank_mask:0xf
    v_and_b32_dpp v180, v243, v5 row_newbcast:4 row_mask:0xf bank_mask:0xf
    v_and_b32_dpp v181, v243, v6 row_newbcast:4 row_mask:0xf bank_mask:0xf
    v_and_b32_dpp v182, v243, v7 row_newbcast:4 row_mask:0xf bank_mask:0xf
    v_and_b32_dpp v183, v243, v8 row_newbcast:4 row_mask:0xf bank_mask:0xf
    s_waitcnt vmcnt(4)
    v_mfma_f32_16x16x32_bf16 v[184:187], v[176:179], v[96:99], 0
    v_and_b32_dpp v176, v243, v5 row_newbcast:8 row_mask:0xf bank_mask:0xf
    v_and_b32_dpp v177, v243, v6 row_newbcast:8 row_mask:0xf bank_mask:0xf
    v_and_b32_dpp v178, v243, v7 row_newbcast:8 row_mask:0xf bank_mask:0xf
    v_and_b32_dpp v179, v243, v8 row_newbcast:8 row_mask:0xf bank_mask:0xf
    v_mfma_f32_16x16x32_bf16 v[184:187], v[180:183], v[100:103], v[184:187]
    v_and_b32_dpp v180, v243, v5 row_newbcast:12 row_mask:0xf bank_mask:0xf
    v_and_b32_dpp v181, v243, v6 row_newbcast:12 row_mask:0xf bank_mask:0xf
    v_and_b32_dpp v182, v243, v7 row_newbcast:12 row_mask:0xf bank_mask:0xf
    v_and_b32_dpp v183, v243, v8 row_newbcast:12 row_mask:0xf bank_mask:0xf
    v_mfma_f32_16x16x32_bf16 v[184:187], v[176:179], v[104:107], v[184:187]
    v_and_b32_dpp v176, v244, v5 row_newbcast:0 row_mask:0xf bank_mask:0xf
    v_and_b32_dpp v177, v244, v6 row_newbcast:0 row_mask:0xf bank_mask:0xf
    v_and_b32_dpp v178, v244, v7 row_newbcast:0 row_mask:0xf bank_mask:0xf
    v_and_b32_dpp v179, v244, v8 row_newbcast:0 row_mask:0xf bank_mask:0xf
    v_mfma_f32_16x16x32_bf16 v[184:187], v[180:183], v[108:111], v[184:187]
    v_and_b32_dpp v180, v244, v5 row_newbcast:4 row_mask:0xf bank_mask:0xf
    v_and_b32_dpp v181, v244, v6 row_newbcast:4 row_mask:0xf bank_mask:0xf
    v_and_b32_dpp v182, v244, v7 row_newbcast:4 row_mask:0xf bank_mask:0xf
    v_and_b32_dpp v183, v244, v8 row_newbcast:4 row_mask:0xf bank_mask:0xf
    v_mfma_f32_16x16x32_bf16 v[184:187], v[176:179], v[112:115], v[184:187]
    v_and_b32_dpp v176, v244, v5 row_newbcast:8 row_mask:0xf bank_mask:0xf
    v_and_b32_dpp v177, v244, v6 row_newbcast:8 row_mask:0xf bank_mask:0xf
    v_and_b32_dpp v178, v244, v7 row_newbcast:8 row_mask:0xf bank_mask:0xf
    v_and_b32_dpp v179, v244, v8 row_newbcast:8 row_mask:0xf bank_mask:0xf
    v_mfma_f32_16x16x32_bf16 v[184:187], v[180:183], v[116:119], v[184:187]
    v_and_b32_dpp v180, v244, v5 row_newbcast:12 row_mask:0xf bank_mask:0xf
    v_and_b32_dpp v181, v244, v6 row_newbcast:12 row_mask:0xf bank_mask:0xf
    v_and_b32_dpp v182, v244, v7 row_newbcast:12 row_mask:0xf bank_mask:0xf
    v_and_b32_dpp v183, v244, v8 row_newbcast:12 row_mask:0xf bank_mask:0xf
    v_mfma_f32_16x16x32_bf16 v[184:187], v[176:179], v[120:123], v[184:187]
    v_and_b32_dpp v176, v245, v5 row_newbcast:0 row_mask:0xf bank_mask:0xf
    v_and_b32_dpp v177, v245, v6 row_newbcast:0 row_mask:0xf bank_mask:0xf
    v_and_b32_dpp v178, v245, v7 row_newbcast:0 row_mask:0xf bank_mask:0xf
    v_and_b32_dpp v179, v245, v8 row_newbcast:0 row_mask:0xf bank_mask:0xf
    v_mfma_f32_16x16x32_bf16 v[184:187], v[180:183], v[124:127], v[184:187]
    v_and_b32_dpp v180, v245, v5 row_newbcast:4 row_mask:0xf bank_mask:0xf
    v_and_b32_dpp v181, v245, v6 row_newbcast:4 row_mask:0xf bank_mask:0xf
    v_and_b32_dpp v182, v245, v7 row_newbcast:4 row_mask:0xf bank_mask:0xf
    v_and_b32_dpp v183, v245, v8 row_newbcast:4 row_mask:0xf bank_mask:0xf
    v_mfma_f32_16x16x32_bf16 v[184:187], v[176:179], v[128:131], v[184:187]
    v_and_b32_dpp v176, v245, v5 row_newbcast:8 row_mask:0xf bank_mask:0xf
    v_and_b32_dpp v177, v245, v6 row_newbcast:8 row_mask:0xf bank_mask:0xf
    v_and_b32_dpp v178, v245, v7 row_newbcast:8 row_mask:0xf bank_mask:0xf
    v_and_b32_dpp v179, v245, v8 row_newbcast:8 row_mask:0xf bank_mask:0xf
    v_mfma_f32_16x16x32_bf16 v[184:187], v[180:183], v[132:135], v[184:187]
    v_and_b32_dpp v180, v245, v5 row_newbcast:12 row_mask:0xf bank_mask:0xf
    v_and_b32_dpp v181, v245, v6 row_newbcast:12 row_mask:0xf bank_mask:0xf
    v_and_b32_dpp v182, v245, v7 row_newbcast:12 row_mask:0xf bank_mask:0xf
    v_and_b32_dpp v183, v245, v8 row_newbcast:12 row_mask:0xf bank_mask:0xf
    v_mfma_f32_16x16x32_bf16 v[184:187], v[176:179], v[136:139], v[184:187]
    v_and_b32_dpp v176, v246, v5 row_newbcast:0 row_mask:0xf bank_mask:0xf
    v_and_b32_dpp v177, v246, v6 row_newbcast:0 row_mask:0xf bank_mask:0xf
    v_and_b32_dpp v178, v246, v7 row_newbcast:0 row_mask:0xf bank_mask:0xf
    v_and_b32_dpp v179, v246, v8 row_newbcast:0 row_mask:0xf bank_mask:0xf
    v_mfma_f32_16x16x32_bf16 v[184:187], v[180:183], v[140:143], v[184:187]
    v_and_b32_dpp v180, v246, v5 row_newbcast:4 row_mask:0xf bank_mask:0xf
    v_and_b32_dpp v181, v246, v6 row_newbcast:4 row_mask:0xf bank_mask:0xf
    v_and_b32_dpp v182, v246, v7 row_newbcast:4 row_mask:0xf bank_mask:0xf
    v_and_b32_dpp v183, v246, v8 row_newbcast:4 row_mask:0xf bank_mask:0xf
    v_mfma_f32_16x16x32_bf16 v[184:187], v[176:179], v[144:147], v[184:187]
    v_and_b32_dpp v176, v246, v5 row_newbcast:8 row_mask:0xf bank_mask:0xf
    v_and_b32_dpp v177, v246, v6 row_newbcast:8 row_mask:0xf bank_mask:0xf
    v_and_b32_dpp v178, v246, v7 row_newbcast:8 row_mask:0xf bank_mask:0xf
    v_and_b32_dpp v179, v246, v8 row_newbcast:8 row_mask:0xf bank_mask:0xf
    v_mfma_f32_16x16x32_bf16 v[184:187], v[180:183], v[148:151], v[184:187]
    v_and_b32_dpp v180, v246, v5 row_newbcast:12 row_mask:0xf bank_mask:0xf
    v_and_b32_dpp v181, v246, v6 row_newbcast:12 row_mask:0xf bank_mask:0xf
    v_and_b32_dpp v182, v246, v7 row_newbcast:12 row_mask:0xf bank_mask:0xf
    v_and_b32_dpp v183, v246, v8 row_newbcast:12 row_mask:0xf bank_mask:0xf
    v_mfma_f32_16x16x32_bf16 v[184:187], v[176:179], v[152:155], v[184:187]
    v_and_b32_dpp v176, v247, v5 row_newbcast:0 row_mask:0xf bank_mask:0xf
    v_and_b32_dpp v177, v247, v6 row_newbcast:0 row_mask:0xf bank_mask:0xf
    v_and_b32_dpp v178, v247, v7 row_newbcast:0 row_mask:0xf bank_mask:0xf
    v_and_b32_dpp v179, v247, v8 row_newbcast:0 row_mask:0xf bank_mask:0xf
    v_mfma_f32_16x16x32_bf16 v[184:187], v[180:183], v[156:159], v[184:187]
    v_and_b32_dpp v180, v247, v5 row_newbcast:4 row_mask:0xf bank_mask:0xf
    v_and_b32_dpp v181, v247, v6 row_newbcast:4 row_mask:0xf bank_mask:0xf
    v_and_b32_dpp v182, v247, v7 row_newbcast:4 row_mask:0xf bank_mask:0xf
    v_and_b32_dpp v183, v247, v8 row_newbcast:4 row_mask:0xf bank_mask:0xf
    s_cmp_lt_u32 s3, 5
    s_cbranch_scc1 L_noew
    s_cmp_eq_u32 s3, 7
    s_cbranch_scc1 L_noew
    v_mov_b32 v13, 0
L_cntml:
    ds_read_b32 v14, v13 offset:14340
    s_waitcnt lgkmcnt(0)
    v_cmp_ne_u32 vcc, 8, v14
    s_cbranch_vccz L_cntml_done
    s_sleep 1
    s_branch L_cntml
L_cntml_done:
    s_sub_u32 s8, s3, 5
    s_lshl_b32 s6, s8, 6
    v_and_b32 v13, 7, v0
    v_lshlrev_b32 v13, 3, v13
    v_add_u32 v13, s6, v13
    ds_read_b64 v[232:233], v13 offset:5248
    s_waitcnt lgkmcnt(0)
    v_mov_b32 v234, v232
    s_nop 1
    v_max_f32_dpp v234, v234, v234 quad_perm:[1,0,3,2] row_mask:0xf bank_mask:0xf
    s_nop 1
    v_max_f32_dpp v234, v234, v234 quad_perm:[2,3,0,1] row_mask:0xf bank_mask:0xf
    s_nop 1
    v_max_f32_dpp v234, v234, v234 row_half_mirror row_mask:0xf bank_mask:0xf
    v_sub_f32 v232, v232, v234
    v_exp_f32 v232, v232
    s_nop 0
    v_mul_f32 v235, v232, v233
    s_nop 1
    v_add_f32_dpp v235, v235, v235 quad_perm:[1,0,3,2] row_mask:0xf bank_mask:0xf
    s_nop 1
    v_add_f32_dpp v235, v235, v235 quad_perm:[2,3,0,1] row_mask:0xf bank_mask:0xf
    s_nop 1
    v_add_f32_dpp v235, v235, v235 row_half_mirror row_mask:0xf bank_mask:0xf
    v_rcp_f32 v233, v235
    v_log_f32 v236, v235
    s_nop 0
    v_mul_f32 v232, v232, v233
    v_add_f32 v236, v236, v234
    s_nop 0
    v_readlane_b32 s52, v232, 0
    v_readlane_b32 s53, v232, 1
    v_readlane_b32 s54, v232, 2
    v_readlane_b32 s55, v232, 3
    v_readlane_b32 s56, v232, 4
    v_readlane_b32 s57, v232, 5
    v_readlane_b32 s58, v232, 6
    v_readlane_b32 s59, v232, 7
L_noew:
    s_cmp_eq_u32 s91, 0
    s_cbranch_scc1 L_nowo
    s_waitcnt vmcnt(2)
    buffer_load_dwordx4 v[16:19], v4, s[44:47], 0 offen nt
    s_movk_i32 s7, 5120
    buffer_load_dwordx4 v[20:23], v4, s[44:47], s7 offen nt
    s_movk_i32 s7, 10240
    buffer_load_dwordx4 v[24:27], v4, s[44:47], s7 offen nt
    s_movk_i32 s7, 15360
    buffer_load_dwordx4 v[28:31], v4, s[44:47], s7 offen nt
    s_movk_i32 s7, 20480
    buffer_load_dwordx4 v[32:35], v4, s[44:47], s7 offen nt
    s_movk_i32 s7, 25600
    buffer_load_dwordx4 v[36:39], v4, s[44:47], s7 offen nt
    s_movk_i32 s7, 30720
    buffer_load_dwordx4 v[40:43], v4, s[44:47], s7 offen nt
    s_mov_b32 s7, 35840
    buffer_load_dwordx4 v[44:47], v4, s[44:47], s7 offen nt
    s_waitcnt vmcnt(8)
    s_branch L_wodone
L_nowo:
    s_waitcnt vmcnt(0)
L_wodone:
    v_mfma_f32_16x16x32_bf16 v[188:191], v[176:179], v[160:163], 0
    v_and_b32_dpp v176, v247, v5 row_newbcast:8 row_mask:0xf bank_mask:0xf
    v_and_b32_dpp v177, v247, v6 row_newbcast:8 row_mask:0xf bank_mask:0xf
    v_and_b32_dpp v178, v247, v7 row_newbcast:8 row_mask:0xf bank_mask:0xf
    v_and_b32_dpp v179, v247, v8 row_newbcast:8 row_mask:0xf bank_mask:0xf
    v_mfma_f32_16x16x32_bf16 v[188:191], v[180:183], v[164:167], v[188:191]
    v_and_b32_dpp v180, v247, v5 row_newbcast:12 row_mask:0xf bank_mask:0xf
    v_and_b32_dpp v181, v247, v6 row_newbcast:12 row_mask:0xf bank_mask:0xf
    v_and_b32_dpp v182, v247, v7 row_newbcast:12 row_mask:0xf bank_mask:0xf
    v_and_b32_dpp v183, v247, v8 row_newbcast:12 row_mask:0xf bank_mask:0xf
    v_mfma_f32_16x16x32_bf16 v[188:191], v[176:179], v[168:171], v[188:191]
    s_nop 1
    v_mfma_f32_16x16x32_bf16 v[188:191], v[180:183], v[172:175], v[188:191]
    s_mov_b32 exec_hi, 0
    ds_write_b128 v250, v[184:187] offset:5632
    s_nop 6
    ds_write_b128 v250, v[188:191] offset:9728
    s_mov_b64 exec, -1
    s_lshl_b32 s7, s4, 1
    s_add_u32 s7, s7, s13
    s_lshl_b32 s7, s7, 13
    s_lshl_b32 s8, s12, 8
    s_add_u32 s7, s7, s8
    s_add_u32 s88, s7, 589824
    s_lshl_b32 s6, s13, 7
    s_lshl_b32 s7, s4, 2
    s_add_u32 s6, s6, s7
    s_add_u32 s6, s6, s12
    s_mul_i32 s6, s6, 2560
    s_lshl_b32 s7, s90, 9
    s_add_u32 s6, s6, s7
    s_add_u32 s89, s6, 1179648
    s_sub_u32 s8, s3, 5
    s_lshl_b32 s6, s4, 1
    s_add_u32 s6, s6, s8
    s_lshl_b32 s6, s6, 3
    s_add_u32 s6, s6, s5
    s_lshl_b32 s6, s6, 10
    s_add_u32 s87, s6, 589824
    s_lshl_b32 s6, s8, 12
    v_lshlrev_b32 v13, 3, v0
    v_add_u32 v13, s6, v13
    s_waitcnt lgkmcnt(0)
    s_barrier
    s_cmp_eq_u32 s91, 1
    s_cbranch_scc1 L_proj
    s_cmp_eq_u32 s3, 4
    s_cbranch_scc1 L_no_proj
    ds_read_b64 v[96:97], v13 offset:5632
    ds_read_b64 v[98:99], v13 offset:6144
    ds_read_b64 v[100:101], v13 offset:6656
    ds_read_b64 v[102:103], v13 offset:7168
    ds_read_b64 v[104:105], v13 offset:7680
    ds_read_b64 v[106:107], v13 offset:8192
    ds_read_b64 v[108:109], v13 offset:8704
    ds_read_b64 v[110:111], v13 offset:9216
    v_mov_b32 v234, v236
    v_mov_b32 v235, s10
    v_mov_b32 v14, 0
    v_mov_b32 v15, 1
    s_waitcnt lgkmcnt(6)
    v_mul_f32 v232, s52, v96
    v_mul_f32 v233, s52, v97
    v_fmac_f32 v232, s53, v98
    v_fmac_f32 v233, s53, v99
    s_waitcnt lgkmcnt(4)
    v_fmac_f32 v232, s54, v100
    v_fmac_f32 v233, s54, v101
    v_fmac_f32 v232, s55, v102
    v_fmac_f32 v233, s55, v103
    s_waitcnt lgkmcnt(2)
    v_fmac_f32 v232, s56, v104
    v_fmac_f32 v233, s56, v105
    v_fmac_f32 v232, s57, v106
    v_fmac_f32 v233, s57, v107
    s_waitcnt lgkmcnt(0)
    v_fmac_f32 v232, s58, v108
    v_fmac_f32 v233, s58, v109
    v_fmac_f32 v232, s59, v110
    v_fmac_f32 v233, s59, v111
    s_cmp_eq_u32 s85, 1
    s_cbranch_scc1 L_pub1_fast
    buffer_store_dwordx4 v[232:235], v1, s[48:51], s87 offen sc1
    s_branch L_pub1_done
L_pub1_fast:
    buffer_store_dwordx4 v[232:235], v1, s[48:51], s87 offen
L_pub1_done:
    s_mov_b64 exec, 1
    ds_add_u32 v14, v15 offset:14352
    s_mov_b64 exec, -1
    s_branch L_fin
L_proj:
    v_and_b32 v12, 7, v11
    v_lshlrev_b32 v12, 5, v12
    v_lshrrev_b32 v13, 1, v10
    v_lshl_add_u32 v12, v13, 4, v12
    s_lshr_b32 s79, s10, 8
    s_lshr_b32 s80, s10, 16
    s_lshr_b32 s81, s10, 24
    s_mov_b32 s76, 0xffff0000
    s_mov_b32 s77, 0xffff0000
    v_mov_b32 v14, 0xff
    v_mov_b32 v13, 0
    s_mov_b32 s11, 400000
L_cntpub:
    ds_read_b32 v15, v13 offset:14352
    s_waitcnt lgkmcnt(0)
    v_cmp_ne_u32 vcc, 2, v15
    s_cbranch_vccnz L_cntpub
L_poll1:
    s_mov_b32 s9, s88
    buffer_load_dwordx4 v[96:99], v12, s[48:51], s9 offen sc1
    s_add_u32 s9, s9, 1024
    buffer_load_dwordx4 v[100:103], v12, s[48:51], s9 offen sc1
    s_add_u32 s9, s9, 1024
    buffer_load_dwordx4 v[104:107], v12, s[48:51], s9 offen sc1
    s_add_u32 s9, s9, 1024
    buffer_load_dwordx4 v[108:111], v12, s[48:51], s9 offen sc1
    s_add_u32 s9, s9, 1024
    buffer_load_dwordx4 v[112:115], v12, s[48:51], s9 offen sc1
    s_add_u32 s9, s9, 1024
    buffer_load_dwordx4 v[116:119], v12, s[48:51], s9 offen sc1
    s_add_u32 s9, s9, 1024
    buffer_load_dwordx4 v[120:123], v12, s[48:51], s9 offen sc1
    s_add_u32 s9, s9, 1024
    buffer_load_dwordx4 v[124:127], v12, s[48:51], s9 offen sc1
    s_waitcnt vmcnt(0)
    v_xor_b32 v228, s10, v99
    v_xor_b32 v229, s10, v103
    v_or_b32 v228, v228, v229
    v_xor_b32 v229, s10, v107
    v_or_b32 v228, v228, v229
    v_xor_b32 v229, s10, v111
    v_or_b32 v228, v228, v229
    v_xor_b32 v229, s10, v115
    v_or_b32 v228, v228, v229
    v_xor_b32 v229, s10, v119
    v_or_b32 v228, v228, v229
    v_xor_b32 v229, s10, v123
    v_or_b32 v228, v228, v229
    v_xor_b32 v229, s10, v127
    v_or_b32 v228, v228, v229
    v_cmp_ne_u32 vcc, 0, v228
    s_cbranch_vccz L_poll1_done
    s_sub_u32 s11, s11, 1
    s_cmp_eq_u32 s11, 0
    s_cbranch_scc0 L_poll1
L_poll1_done:
    v_max3_f32 v230, v98, v102, v106
    v_max3_f32 v230, v230, v110, v114
    v_max3_f32 v230, v230, v118, v122
    v_max_f32 v230, v230, v126
    v_sub_f32 v98, v98, v230
    v_sub_f32 v102, v102, v230
    v_sub_f32 v106, v106, v230
    v_sub_f32 v110, v110, v230
    v_sub_f32 v114, v114, v230
    v_sub_f32 v118, v118, v230
    v_sub_f32 v122, v122, v230
    v_sub_f32 v126, v126, v230
    v_exp_f32 v98, v98
    v_exp_f32 v102, v102
    v_exp_f32 v106, v106
    v_exp_f32 v110, v110
    v_exp_f32 v114, v114
    v_exp_f32 v118, v118
    v_exp_f32 v122, v122
    v_exp_f32 v126, v126
    s_nop 0
    v_mul_f32 v232, v98, v96
    v_mul_f32 v233, v98, v97
    v_mov_b32 v234, v98
    v_fmac_f32 v232, v102, v100
    v_fmac_f32 v233, v102, v101
    v_add_f32 v234, v234, v102
    v_fmac_f32 v232, v106, v104
    v_fmac_f32 v233, v106, v105
    v_add_f32 v234, v234, v106
    v_fmac_f32 v232, v110, v108
    v_fmac_f32 v233, v110, v109
    v_add_f32 v234, v234, v110
    v_fmac_f32 v232, v114, v112
    v_fmac_f32 v233, v114, v113
    v_add_f32 v234, v234, v114
    v_fmac_f32 v232, v118, v116
    v_fmac_f32 v233, v118, v117
    v_add_f32 v234, v234, v118
    v_fmac_f32 v232, v122, v120
    v_fmac_f32 v233, v122, v121
    v_add_f32 v234, v234, v122
    v_fmac_f32 v232, v126, v124
    v_fmac_f32 v233, v126, v125
    v_add_f32 v234, v234, v126
    v_rcp_f32 v234, v234
    v_cndmask_b32_e64 v232, v232, v233, s[76:77]
    v_mul_f32 v232, v232, v234
    v_cvt_pk_bf16_f32 v236, v232, v232
    s_nop 1
    v_and_b32_dpp v176, v236, v5 row_newbcast:0 row_mask:0xf bank_mask:0xf
    v_and_b32_dpp v177, v236, v6 row_newbcast:0 row_mask:0xf bank_mask:0xf
    v_and_b32_dpp v178, v236, v7 row_newbcast:0 row_mask:0xf bank_mask:0xf
    v_and_b32_dpp v179, v236, v8 row_newbcast:0 row_mask:0xf bank_mask:0xf
    v_and_b32_dpp v180, v236, v5 row_newbcast:1 row_mask:0xf bank_mask:0xf
    v_and_b32_dpp v181, v236, v6 row_newbcast:1 row_mask:0xf bank_mask:0xf
    v_and_b32_dpp v182, v236, v7 row_newbcast:1 row_mask:0xf bank_mask:0xf
    v_and_b32_dpp v183, v236, v8 row_newbcast:1 row_mask:0xf bank_mask:0xf
    v_mfma_f32_16x16x32_bf16 v[192:195], v[176:179], v[16:19], 0
    v_and_b32_dpp v176, v236, v5 row_newbcast:2 row_mask:0xf bank_mask:0xf
    v_and_b32_dpp v177, v236, v6 row_newbcast:2 row_mask:0xf bank_mask:0xf
    v_and_b32_dpp v178, v236, v7 row_newbcast:2 row_mask:0xf bank_mask:0xf
    v_and_b32_dpp v179, v236, v8 row_newbcast:2 row_mask:0xf bank_mask:0xf
    v_mfma_f32_16x16x32_bf16 v[192:195], v[180:183], v[20:23], v[192:195]
    v_and_b32_dpp v180, v236, v5 row_newbcast:3 row_mask:0xf bank_mask:0xf
    v_and_b32_dpp v181, v236, v6 row_newbcast:3 row_mask:0xf bank_mask:0xf
    v_and_b32_dpp v182, v236, v7 row_newbcast:3 row_mask:0xf bank_mask:0xf
    v_and_b32_dpp v183, v236, v8 row_newbcast:3 row_mask:0xf bank_mask:0xf
    v_mfma_f32_16x16x32_bf16 v[192:195], v[176:179], v[24:27], v[192:195]
    v_and_b32_dpp v176, v236, v5 row_newbcast:4 row_mask:0xf bank_mask:0xf
    v_and_b32_dpp v177, v236, v6 row_newbcast:4 row_mask:0xf bank_mask:0xf
    v_and_b32_dpp v178, v236, v7 row_newbcast:4 row_mask:0xf bank_mask:0xf
    v_and_b32_dpp v179, v236, v8 row_newbcast:4 row_mask:0xf bank_mask:0xf
    v_mfma_f32_16x16x32_bf16 v[192:195], v[180:183], v[28:31], v[192:195]
    v_and_b32_dpp v180, v236, v5 row_newbcast:5 row_mask:0xf bank_mask:0xf
    v_and_b32_dpp v181, v236, v6 row_newbcast:5 row_mask:0xf bank_mask:0xf
    v_and_b32_dpp v182, v236, v7 row_newbcast:5 row_mask:0xf bank_mask:0xf
    v_and_b32_dpp v183, v236, v8 row_newbcast:5 row_mask:0xf bank_mask:0xf
    v_mfma_f32_16x16x32_bf16 v[192:195], v[176:179], v[32:35], v[192:195]
    v_and_b32_dpp v176, v236, v5 row_newbcast:6 row_mask:0xf bank_mask:0xf
    v_and_b32_dpp v177, v236, v6 row_newbcast:6 row_mask:0xf bank_mask:0xf
    v_and_b32_dpp v178, v236, v7 row_newbcast:6 row_mask:0xf bank_mask:0xf
    v_and_b32_dpp v179, v236, v8 row_newbcast:6 row_mask:0xf bank_mask:0xf
    v_mfma_f32_16x16x32_bf16 v[192:195], v[180:183], v[36:39], v[192:195]
    v_and_b32_dpp v180, v236, v5 row_newbcast:7 row_mask:0xf bank_mask:0xf
    v_and_b32_dpp v181, v236, v6 row_newbcast:7 row_mask:0xf bank_mask:0xf
    v_and_b32_dpp v182, v236, v7 row_newbcast:7 row_mask:0xf bank_mask:0xf
    v_and_b32_dpp v183, v236, v8 row_newbcast:7 row_mask:0xf bank_mask:0xf
    v_mfma_f32_16x16x32_bf16 v[192:195], v[176:179], v[40:43], v[192:195]
    s_nop 1
    v_mfma_f32_16x16x32_bf16 v[192:195], v[180:183], v[44:47], v[192:195]
    s_nop 7
    v_bfi_b32 v232, v14, s10, v192
    v_bfi_b32 v233, v14, s79, v193
    v_bfi_b32 v234, v14, s80, v194
    v_bfi_b32 v235, v14, s81, v195
    s_mov_b32 exec_hi, 0
    buffer_store_dwordx4 v[232:235], v1, s[48:51], s89 offen sc1
    s_mov_b64 exec, -1
    s_cmp_eq_u32 s92, 0
    s_cbranch_scc1 L_noE
    s_barrier
L_noE:
    s_branch L_fin
L_no_proj:
    s_cmp_lg_u32 s3, 4
    s_cbranch_scc1 L_fin
    s_cmp_eq_u32 s92, 0
    s_cbranch_scc1 L_fin
    s_mov_b32 s6, s93
    s_cmp_ge_u32 s6, 40
    s_cselect_b32 s13, 1, 0
    s_mul_i32 s7, s13, 40
    s_sub_u32 s12, s6, s7
    s_mul_i32 s8, s13, 327680
    s_lshl_b32 s9, s12, 6
    s_add_u32 s8, s8, s9
    s_add_u32 s8, s8, 1179648
    v_lshrrev_b32 v12, 2, v0
    v_mul_u32_u24 v12, 2560, v12
    v_and_b32 v13, 3, v0
    v_lshl_add_u32 v12, v13, 4, v12
    s_mov_b64 s[52:53], -1
    s_mov_b64 s[54:55], -1
    s_mov_b64 s[56:57], -1
    s_mov_b64 s[58:59], -1
    s_mov_b64 s[60:61], -1
    s_mov_b64 s[62:63], -1
    s_mov_b64 s[64:65], -1
    s_mov_b64 s[66:67], -1
    s_mov_b32 s84, 0x0c0c0400
    s_not_b32 s9, s10
    v_mov_b32 v16, s9
    v_mov_b32 v48, s9
    v_mov_b32 v20, s9
    v_mov_b32 v52, s9
    v_mov_b32 v24, s9
    v_mov_b32 v56, s9
    v_mov_b32 v28, s9
    v_mov_b32 v60, s9
    v_mov_b32 v32, s9
    v_mov_b32 v64, s9
    v_mov_b32 v36, s9
    v_mov_b32 v68, s9
    v_mov_b32 v40, s9
    v_mov_b32 v72, s9
    v_mov_b32 v44, s9
    v_mov_b32 v76, s9
    s_mul_i32 s87, s13, 1280
    s_lshr_b32 s7, s12, 3
    s_lshl_b32 s7, s7, 8
    s_add_u32 s87, s87, s7
    s_and_b32 s7, s12, 3
    s_lshl_b32 s7, s7, 6
    s_add_u32 s87, s87, s7
    s_bfe_u32 s7, s12, 0x10002
    s_lshl_b32 s7, s7, 3
    s_add_u32 s87, s87, s7
    v_lshlrev_b32 v14, 4, v0
    s_mov_b32 s68, s36
    s_mov_b32 s69, s37
    s_mov_b32 s70, 2560
    s_mov_b32 s71, 0x20000
    s_mov_b32 s11, 400000
    s_barrier
    s_mov_b32 s9, s8
    s_mov_b64 exec, s[52:53]
    buffer_load_dwordx4 v[48:51], v12, s[48:51], s9 offen sc1
    s_add_u32 s9, s9, 40960
    s_mov_b64 exec, s[54:55]
    buffer_load_dwordx4 v[52:55], v12, s[48:51], s9 offen sc1
    s_add_u32 s9, s9, 40960
    s_mov_b64 exec, s[56:57]
    buffer_load_dwordx4 v[56:59], v12, s[48:51], s9 offen sc1
    s_add_u32 s9, s9, 40960
    s_mov_b64 exec, s[58:59]
    buffer_load_dwordx4 v[60:63], v12, s[48:51], s9 offen sc1
    s_add_u32 s9, s9, 40960
    s_mov_b64 exec, s[60:61]
    buffer_load_dwordx4 v[64:67], v12, s[48:51], s9 offen sc1
    s_add_u32 s9, s9, 40960
    s_mov_b64 exec, s[62:63]
    buffer_load_dwordx4 v[68:71], v12, s[48:51], s9 offen sc1
    s_add_u32 s9, s9, 40960
    s_mov_b64 exec, s[64:65]
    buffer_load_dwordx4 v[72:75], v12, s[48:51], s9 offen sc1
    s_add_u32 s9, s9, 40960
    s_mov_b64 exec, s[66:67]
    buffer_load_dwordx4 v[76:79], v12, s[48:51], s9 offen sc1
    s_mov_b64 exec, -1
L_poll2:
    s_mov_b32 s9, s8
    s_mov_b64 exec, s[52:53]
    buffer_load_dwordx4 v[16:19], v12, s[48:51], s9 offen sc1
    s_add_u32 s9, s9, 40960
    s_mov_b64 exec, s[54:55]
    buffer_load_dwordx4 v[20:23], v12, s[48:51], s9 offen sc1
    s_add_u32 s9, s9, 40960
    s_mov_b64 exec, s[56:57]
    buffer_load_dwordx4 v[24:27], v12, s[48:51], s9 offen sc1
    s_add_u32 s9, s9, 40960
    s_mov_b64 exec, s[58:59]
    buffer_load_dwordx4 v[28:31], v12, s[48:51], s9 offen sc1
    s_add_u32 s9, s9, 40960
    s_mov_b64 exec, s[60:61]
    buffer_load_dwordx4 v[32:35], v12, s[48:51], s9 offen sc1
    s_add_u32 s9, s9, 40960
    s_mov_b64 exec, s[62:63]
    buffer_load_dwordx4 v[36:39], v12, s[48:51], s9 offen sc1
    s_add_u32 s9, s9, 40960
    s_mov_b64 exec, s[64:65]
    buffer_load_dwordx4 v[40:43], v12, s[48:51], s9 offen sc1
    s_add_u32 s9, s9, 40960
    s_mov_b64 exec, s[66:67]
    buffer_load_dwordx4 v[44:47], v12, s[48:51], s9 offen sc1
    s_mov_b64 exec, -1
    s_waitcnt vmcnt(8)
    s_cmp_eq_u64 s[52:53], 0
    s_cbranch_scc1 L_mg1_0
    v_perm_b32 v228, v49, v48, s84
    v_perm_b32 v229, v51, v50, s84
    v_lshl_or_b32 v228, v229, 16, v228
    v_cmp_eq_u32 vcc, s10, v228
    s_and_b64 exec, vcc, s[52:53]
    s_andn2_b64 s[52:53], s[52:53], vcc
    v_and_b32 v96, 0xffffff00, v48
    v_and_b32 v97, 0xffffff00, v49
    v_and_b32 v98, 0xffffff00, v50
    v_and_b32 v99, 0xffffff00, v51
    s_mov_b64 exec, -1
L_mg1_0:
    s_cmp_eq_u64 s[54:55], 0
    s_cbranch_scc1 L_mg1_1
    v_perm_b32 v228, v53, v52, s84
    v_perm_b32 v229, v55, v54, s84
    v_lshl_or_b32 v228, v229, 16, v228
    v_cmp_eq_u32 vcc, s10, v228
    s_and_b64 exec, vcc, s[54:55]
    s_andn2_b64 s[54:55], s[54:55], vcc
    v_and_b32 v100, 0xffffff00, v52
    v_and_b32 v101, 0xffffff00, v53
    v_and_b32 v102, 0xffffff00, v54
    v_and_b32 v103, 0xffffff00, v55
    s_mov_b64 exec, -1
L_mg1_1:
    s_cmp_eq_u64 s[56:57], 0
    s_cbranch_scc1 L_mg1_2
    v_perm_b32 v228, v57, v56, s84
    v_perm_b32 v229, v59, v58, s84
    v_lshl_or_b32 v228, v229, 16, v228
    v_cmp_eq_u32 vcc, s10, v228
    s_and_b64 exec, vcc, s[56:57]
    s_andn2_b64 s[56:57], s[56:57], vcc
    v_and_b32 v104, 0xffffff00, v56
    v_and_b32 v105, 0xffffff00, v57
    v_and_b32 v106, 0xffffff00, v58
    v_and_b32 v107, 0xffffff00, v59
    s_mov_b64 exec, -1
L_mg1_2:
    s_cmp_eq_u64 s[58:59], 0
    s_cbranch_scc1 L_mg1_3
    v_perm_b32 v228, v61, v60, s84
    v_perm_b32 v229, v63, v62, s84
    v_lshl_or_b32 v228, v229, 16, v228
    v_cmp_eq_u32 vcc, s10, v228
    s_and_b64 exec, vcc, s[58:59]
    s_andn2_b64 s[58:59], s[58:59], vcc
    v_and_b32 v108, 0xffffff00, v60
    v_and_b32 v109, 0xffffff00, v61
    v_and_b32 v110, 0xffffff00, v62
    v_and_b32 v111, 0xffffff00, v63
    s_mov_b64 exec, -1
L_mg1_3:
    s_cmp_eq_u64 s[60:61], 0
    s_cbranch_scc1 L_mg1_4
    v_perm_b32 v228, v65, v64, s84
    v_perm_b32 v229, v67, v66, s84
    v_lshl_or_b32 v228, v229, 16, v228
    v_cmp_eq_u32 vcc, s10, v228
    s_and_b64 exec, vcc, s[60:61]
    s_andn2_b64 s[60:61], s[60:61], vcc
    v_and_b32 v112, 0xffffff00, v64
    v_and_b32 v113, 0xffffff00, v65
    v_and_b32 v114, 0xffffff00, v66
    v_and_b32 v115, 0xffffff00, v67
    s_mov_b64 exec, -1
L_mg1_4:
    s_cmp_eq_u64 s[62:63], 0
    s_cbranch_scc1 L_mg1_5
    v_perm_b32 v228, v69, v68, s84
    v_perm_b32 v229, v71, v70, s84
    v_lshl_or_b32 v228, v229, 16, v228
    v_cmp_eq_u32 vcc, s10, v228
    s_and_b64 exec, vcc, s[62:63]
    s_andn2_b64 s[62:63], s[62:63], vcc
    v_and_b32 v116, 0xffffff00, v68
    v_and_b32 v117, 0xffffff00, v69
    v_and_b32 v118, 0xffffff00, v70
    v_and_b32 v119, 0xffffff00, v71
    s_mov_b64 exec, -1
L_mg1_5:
    s_cmp_eq_u64 s[64:65], 0
    s_cbranch_scc1 L_mg1_6
    v_perm_b32 v228, v73, v72, s84
    v_perm_b32 v229, v75, v74, s84
    v_lshl_or_b32 v228, v229, 16, v228
    v_cmp_eq_u32 vcc, s10, v228
    s_and_b64 exec, vcc, s[64:65]
    s_andn2_b64 s[64:65], s[64:65], vcc
    v_and_b32 v120, 0xffffff00, v72
    v_and_b32 v121, 0xffffff00, v73
    v_and_b32 v122, 0xffffff00, v74
    v_and_b32 v123, 0xffffff00, v75
    s_mov_b64 exec, -1
L_mg1_6:
    s_cmp_eq_u64 s[66:67], 0
    s_cbranch_scc1 L_mg1_7
    v_perm_b32 v228, v77, v76, s84
    v_perm_b32 v229, v79, v78, s84
    v_lshl_or_b32 v228, v229, 16, v228
    v_cmp_eq_u32 vcc, s10, v228
    s_and_b64 exec, vcc, s[66:67]
    s_andn2_b64 s[66:67], s[66:67], vcc
    v_and_b32 v124, 0xffffff00, v76
    v_and_b32 v125, 0xffffff00, v77
    v_and_b32 v126, 0xffffff00, v78
    v_and_b32 v127, 0xffffff00, v79
    s_mov_b64 exec, -1
L_mg1_7:
    s_or_b64 s[94:95], s[52:53], s[54:55]
    s_or_b64 s[94:95], s[94:95], s[56:57]
    s_or_b64 s[94:95], s[94:95], s[58:59]
    s_or_b64 s[94:95], s[94:95], s[60:61]
    s_or_b64 s[94:95], s[94:95], s[62:63]
    s_or_b64 s[94:95], s[94:95], s[64:65]
    s_or_b64 s[94:95], s[94:95], s[66:67]
    s_cbranch_scc0 L_poll2_done
    s_mov_b32 s9, s8
    s_mov_b64 exec, s[52:53]
    buffer_load_dwordx4 v[48:51], v12, s[48:51], s9 offen sc1
    s_add_u32 s9, s9, 40960
    s_mov_b64 exec, s[54:55]
    buffer_load_dwordx4 v[52:55], v12, s[48:51], s9 offen sc1
    s_add_u32 s9, s9, 40960
    s_mov_b64 exec, s[56:57]
    buffer_load_dwordx4 v[56:59], v12, s[48:51], s9 offen sc1
    s_add_u32 s9, s9, 40960
    s_mov_b64 exec, s[58:59]
    buffer_load_dwordx4 v[60:63], v12, s[48:51], s9 offen sc1
    s_add_u32 s9, s9, 40960
    s_mov_b64 exec, s[60:61]
    buffer_load_dwordx4 v[64:67], v12, s[48:51], s9 offen sc1
    s_add_u32 s9, s9, 40960
    s_mov_b64 exec, s[62:63]
    buffer_load_dwordx4 v[68:71], v12, s[48:51], s9 offen sc1
    s_add_u32 s9, s9, 40960
    s_mov_b64 exec, s[64:65]
    buffer_load_dwordx4 v[72:75], v12, s[48:51], s9 offen sc1
    s_add_u32 s9, s9, 40960
    s_mov_b64 exec, s[66:67]
    buffer_load_dwordx4 v[76:79], v12, s[48:51], s9 offen sc1
    s_mov_b64 exec, -1
    s_waitcnt vmcnt(8)
    s_cmp_eq_u64 s[52:53], 0
    s_cbranch_scc1 L_mg2_0
    v_perm_b32 v228, v17, v16, s84
    v_perm_b32 v229, v19, v18, s84
    v_lshl_or_b32 v228, v229, 16, v228
    v_cmp_eq_u32 vcc, s10, v228
    s_and_b64 exec, vcc, s[52:53]
    s_andn2_b64 s[52:53], s[52:53], vcc
    v_and_b32 v96, 0xffffff00, v16
    v_and_b32 v97, 0xffffff00, v17
    v_and_b32 v98, 0xffffff00, v18
    v_and_b32 v99, 0xffffff00, v19
    s_mov_b64 exec, -1
L_mg2_0:
    s_cmp_eq_u64 s[54:55], 0
    s_cbranch_scc1 L_mg2_1
    v_perm_b32 v228, v21, v20, s84
    v_perm_b32 v229, v23, v22, s84
    v_lshl_or_b32 v228, v229, 16, v228
    v_cmp_eq_u32 vcc, s10, v228
    s_and_b64 exec, vcc, s[54:55]
    s_andn2_b64 s[54:55], s[54:55], vcc
    v_and_b32 v100, 0xffffff00, v20
    v_and_b32 v101, 0xffffff00, v21
    v_and_b32 v102, 0xffffff00, v22
    v_and_b32 v103, 0xffffff00, v23
    s_mov_b64 exec, -1
L_mg2_1:
    s_cmp_eq_u64 s[56:57], 0
    s_cbranch_scc1 L_mg2_2
    v_perm_b32 v228, v25, v24, s84
    v_perm_b32 v229, v27, v26, s84
    v_lshl_or_b32 v228, v229, 16, v228
    v_cmp_eq_u32 vcc, s10, v228
    s_and_b64 exec, vcc, s[56:57]
    s_andn2_b64 s[56:57], s[56:57], vcc
    v_and_b32 v104, 0xffffff00, v24
    v_and_b32 v105, 0xffffff00, v25
    v_and_b32 v106, 0xffffff00, v26
    v_and_b32 v107, 0xffffff00, v27
    s_mov_b64 exec, -1
L_mg2_2:
    s_cmp_eq_u64 s[58:59], 0
    s_cbranch_scc1 L_mg2_3
    v_perm_b32 v228, v29, v28, s84
    v_perm_b32 v229, v31, v30, s84
    v_lshl_or_b32 v228, v229, 16, v228
    v_cmp_eq_u32 vcc, s10, v228
    s_and_b64 exec, vcc, s[58:59]
    s_andn2_b64 s[58:59], s[58:59], vcc
    v_and_b32 v108, 0xffffff00, v28
    v_and_b32 v109, 0xffffff00, v29
    v_and_b32 v110, 0xffffff00, v30
    v_and_b32 v111, 0xffffff00, v31
    s_mov_b64 exec, -1
L_mg2_3:
    s_cmp_eq_u64 s[60:61], 0
    s_cbranch_scc1 L_mg2_4
    v_perm_b32 v228, v33, v32, s84
    v_perm_b32 v229, v35, v34, s84
    v_lshl_or_b32 v228, v229, 16, v228
    v_cmp_eq_u32 vcc, s10, v228
    s_and_b64 exec, vcc, s[60:61]
    s_andn2_b64 s[60:61], s[60:61], vcc
    v_and_b32 v112, 0xffffff00, v32
    v_and_b32 v113, 0xffffff00, v33
    v_and_b32 v114, 0xffffff00, v34
    v_and_b32 v115, 0xffffff00, v35
    s_mov_b64 exec, -1
L_mg2_4:
    s_cmp_eq_u64 s[62:63], 0
    s_cbranch_scc1 L_mg2_5
    v_perm_b32 v228, v37, v36, s84
    v_perm_b32 v229, v39, v38, s84
    v_lshl_or_b32 v228, v229, 16, v228
    v_cmp_eq_u32 vcc, s10, v228
    s_and_b64 exec, vcc, s[62:63]
    s_andn2_b64 s[62:63], s[62:63], vcc
    v_and_b32 v116, 0xffffff00, v36
    v_and_b32 v117, 0xffffff00, v37
    v_and_b32 v118, 0xffffff00, v38
    v_and_b32 v119, 0xffffff00, v39
    s_mov_b64 exec, -1
L_mg2_5:
    s_cmp_eq_u64 s[64:65], 0
    s_cbranch_scc1 L_mg2_6
    v_perm_b32 v228, v41, v40, s84
    v_perm_b32 v229, v43, v42, s84
    v_lshl_or_b32 v228, v229, 16, v228
    v_cmp_eq_u32 vcc, s10, v228
    s_and_b64 exec, vcc, s[64:65]
    s_andn2_b64 s[64:65], s[64:65], vcc
    v_and_b32 v120, 0xffffff00, v40
    v_and_b32 v121, 0xffffff00, v41
    v_and_b32 v122, 0xffffff00, v42
    v_and_b32 v123, 0xffffff00, v43
    s_mov_b64 exec, -1
L_mg2_6:
    s_cmp_eq_u64 s[66:67], 0
    s_cbranch_scc1 L_mg2_7
    v_perm_b32 v228, v45, v44, s84
    v_perm_b32 v229, v47, v46, s84
    v_lshl_or_b32 v228, v229, 16, v228
    v_cmp_eq_u32 vcc, s10, v228
    s_and_b64 exec, vcc, s[66:67]
    s_andn2_b64 s[66:67], s[66:67], vcc
    v_and_b32 v124, 0xffffff00, v44
    v_and_b32 v125, 0xffffff00, v45
    v_and_b32 v126, 0xffffff00, v46
    v_and_b32 v127, 0xffffff00, v47
    s_mov_b64 exec, -1
L_mg2_7:
    s_or_b64 s[94:95], s[52:53], s[54:55]
    s_or_b64 s[94:95], s[94:95], s[56:57]
    s_or_b64 s[94:95], s[94:95], s[58:59]
    s_or_b64 s[94:95], s[94:95], s[60:61]
    s_or_b64 s[94:95], s[94:95], s[62:63]
    s_or_b64 s[94:95], s[94:95], s[64:65]
    s_or_b64 s[94:95], s[94:95], s[66:67]
    s_cbranch_scc0 L_poll2_done
    s_sub_u32 s11, s11, 1
    s_cmp_eq_u32 s11, 0
    s_cbranch_scc0 L_poll2
L_poll2_done:
    v_pk_add_f32 v[96:97], v[96:97], v[112:113]
    v_pk_add_f32 v[98:99], v[98:99], v[114:115]
    v_pk_add_f32 v[100:101], v[100:101], v[116:117]
    v_pk_add_f32 v[102:103], v[102:103], v[118:119]
    v_pk_add_f32 v[104:105], v[104:105], v[120:121]
    v_pk_add_f32 v[106:107], v[106:107], v[122:123]
    v_pk_add_f32 v[108:109], v[108:109], v[124:125]
    v_pk_add_f32 v[110:111], v[110:111], v[126:127]
    v_pk_add_f32 v[96:97], v[96:97], v[104:105]
    v_pk_add_f32 v[98:99], v[98:99], v[106:107]
    v_pk_add_f32 v[100:101], v[100:101], v[108:109]
    v_pk_add_f32 v[102:103], v[102:103], v[110:111]
    v_pk_add_f32 v[96:97], v[96:97], v[100:101]
    v_pk_add_f32 v[98:99], v[98:99], v[102:103]
    s_nop 0
    v_add_f32_dpp v96, v96, v96 row_ror:4 row_mask:0xf bank_mask:0xf
    v_add_f32_dpp v97, v97, v97 row_ror:4 row_mask:0xf bank_mask:0xf
    v_add_f32_dpp v98, v98, v98 row_ror:4 row_mask:0xf bank_mask:0xf
    v_add_f32_dpp v99, v99, v99 row_ror:4 row_mask:0xf bank_mask:0xf
    s_nop 0
    v_add_f32_dpp v96, v96, v96 row_ror:8 row_mask:0xf bank_mask:0xf
    v_add_f32_dpp v97, v97, v97 row_ror:8 row_mask:0xf bank_mask:0xf
    v_add_f32_dpp v98, v98, v98 row_ror:8 row_mask:0xf bank_mask:0xf
    v_add_f32_dpp v99, v99, v99 row_ror:8 row_mask:0xf bank_mask:0xf
    v_mov_b32 v100, v96
    v_mov_b32 v101, v97
    v_mov_b32 v102, v98
    v_mov_b32 v103, v99
    s_nop 0
    v_permlane16_swap_b32 v96, v100
    v_permlane16_swap_b32 v97, v101
    v_permlane16_swap_b32 v98, v102
    v_permlane16_swap_b32 v99, v103
    s_nop 0
    v_pk_add_f32 v[96:97], v[96:97], v[100:101]
    v_pk_add_f32 v[98:99], v[98:99], v[102:103]
    v_mov_b32 v100, v96
    v_mov_b32 v101, v97
    v_mov_b32 v102, v98
    v_mov_b32 v103, v99
    s_nop 0
    v_permlane32_swap_b32 v96, v100
    v_permlane32_swap_b32 v97, v101
    v_permlane32_swap_b32 v98, v102
    v_permlane32_swap_b32 v99, v103
    s_nop 0
    v_pk_add_f32 v[96:97], v[96:97], v[100:101]
    v_pk_add_f32 v[98:99], v[98:99], v[102:103]
    v_cvt_pk_bf16_f32 v104, v96, v97
    v_cvt_pk_bf16_f32 v105, v98, v99
    s_mov_b64 exec, 0xf
    buffer_store_dwordx2 v[104:105], v14, s[68:71], s87 offen
    s_cmp_lg_u32 s2, 0
    s_cbranch_scc1 L_fin2
    s_mov_b64 exec, 1
    v_mov_b32 v14, 0
    v_mov_b32 v15, s10
    global_store_dword v14, v15, s[40:41]
L_fin2:
    s_mov_b64 exec, -1
L_fin:
L_end:
    s_endpgm
.section .rodata,"a"
.p2align 6
.amdhsa_kernel concat_heads__gqa_block_cached__sliding_block_cached__decode_kernel
  .amdhsa_next_free_vgpr 256
  .amdhsa_next_free_sgpr 102
  .amdhsa_accum_offset 256
  .amdhsa_group_segment_fixed_size 0
  .amdhsa_kernarg_size 104
  .amdhsa_user_sgpr_count 2
  .amdhsa_user_sgpr_kernarg_segment_ptr 1
  .amdhsa_system_sgpr_workgroup_id_x 1
  .amdhsa_float_denorm_mode_32 3
.end_amdhsa_kernel
.text
```
